```python
import torch

def _softmax(x, axis=-1):
    return torch.softmax(x, dim=axis)
def _gelu(x):
    return torch.nn.functional.gelu(x, approximate="tanh")
def _silu(x):
    return torch.nn.functional.silu(x)
def _sigmoid(x):
    return torch.sigmoid(x)
def _layernorm(x, axis=-1, eps=1e-5):
    m = x.mean(dim=axis, keepdim=True)
    v = x.var(dim=axis, keepdim=True, unbiased=False)
    return (x - m) / torch.sqrt(v + eps)
def _scatter_add(tgt, idx, src, axis=0):
    return tgt.clone().index_add_(axis, idx, src)
def _segment_sum(src, seg, n):
    out = torch.zeros((n,) + src.shape[1:], dtype=src.dtype)
    return out.index_add_(0, seg, src)
def _pad(x, pw):
    flat = tuple(v for pair in reversed(pw) for v in pair)
    return torch.nn.functional.pad(x, flat)

kernel_name = 'standalone__window_attn_swin__vision'

def setup_inputs():

    _w = (lambda a: (lambda t: t.to(torch.bfloat16) if t.is_floating_point() else t)(torch.as_tensor(a)))
    H = W = 224
    C = 96
    ws = 7
    nh = 4
    shift = ws // 2
    coords = torch.stack(torch.meshgrid(torch.arange(ws), torch.arange(ws), indexing='ij'), 0).reshape(2, -1)
    rel = coords[:, :, None] - coords[:, None, :]
    rel[0] += ws - 1
    rel[1] += ws - 1
    rel[0] *= 2 * ws - 1
    rp_idx = rel.sum(0).to(torch.int64)
    img_mask = torch.zeros((1, H, W, 1), dtype=float)
    cnt = 0
    for hs in (slice(0, H - ws), slice(H - ws, H - shift), slice(H - shift, H)):
        for vs in (slice(0, W - ws), slice(W - ws, W - shift), slice(W - shift, W)):
            img_mask[:, hs, vs, :] = cnt
            cnt += 1
    mw = img_mask.reshape(1, H // ws, ws, W // ws, ws, 1).permute(0, 1, 3, 2, 4, 5).reshape(-1, ws * ws)
    am = mw[:, :, None] - mw[:, None, :]
    attn_mask = torch.where(am != 0, -100.0, 0.0).to(float)
    return {
        "x": _w((lambda *s: torch.randn(*s, dtype=torch.bfloat16) * 1.6)(1, H, W, C)),
        "wqkv": _w((lambda *s: torch.randn(*s, dtype=torch.bfloat16) * 1.6)(C, 3 * C) * 0.02),
        "wo": _w((lambda *s: torch.randn(*s, dtype=torch.bfloat16) * 0.05)(C, C) * 0.02),
        "rpb": _w((lambda *s: torch.randn(*s, dtype=torch.bfloat16) * 0.4)((2 * ws - 1) * (2 * ws - 1), nh)),
        "rp_idx": _w(rp_idx),
        "attn_mask": _w(attn_mask),
    }

def reference(x, wqkv, wo, rpb, rp_idx, attn_mask):
    B, H, W, C = x.shape
    N = rp_idx.shape[0]
    ws = int(round(N ** 0.5))
    nh = rpb.shape[-1]
    hd = C // nh
    shift = ws // 2
    xs = torch.roll(x, (-shift, -shift), (1, 2))
    nWh = H // ws
    nWw = W // ws
    xw = (lambda x, *d: x.permute(*d))(xs.reshape(B, nWh, ws, nWw, ws, C), 0, 1, 3, 2, 4, 5).reshape(B * nWh * nWw, N, C)
    qkv = (lambda x, *d: x.permute(*d))(torch.einsum('wnc,cd->wnd', xw, wqkv).reshape(-1, N, 3, nh, hd), 2, 0, 3, 1, 4)
    q, k, v = qkv[0], qkv[1], qkv[2]
    attn = torch.einsum('whid,whjd->whij', q, k) * (hd ** -0.5)
    bias = (lambda x, *d: x.permute(*d))(rpb[rp_idx.reshape(-1)].reshape(N, N, nh), 2, 0, 1)
    attn = attn + bias[None, :, :, :]
    attn = (attn.reshape(B, nWh * nWw, nh, N, N) + attn_mask[None, :, None, :, :]).reshape(-1, nh, N, N)
    attn = _softmax(attn, axis=-1)
    out = (lambda x, *d: x.permute(*d))(torch.einsum('whij,whjd->whid', attn, v), 0, 2, 1, 3).reshape(-1, N, C)
    out = torch.einsum('wnc,cd->wnd', out, wo)
    out = (lambda x, *d: x.permute(*d))(out.reshape(B, nWh, nWw, ws, ws, C), 0, 1, 3, 2, 4, 5).reshape(B, H, W, C)
    return torch.roll(out, (shift, shift), (1, 2))
```

```asm
; @launch grid=(256,1,1) block=(512,1,1) lds=163840
.amdgcn_target "amdgcn-amd-amdhsa--gfx950"
.text
.globl standalone__window_attn_swin__vision_kernel
.p2align 8
.type standalone__window_attn_swin__vision_kernel,@function
standalone__window_attn_swin__vision_kernel:
    s_cmp_ge_u32 s2, 256
    s_cbranch_scc1 L_end
    s_load_dwordx2 s[20:21], s[0:1], 8
    s_load_dwordx2 s[16:17], s[0:1], 0
    v_readfirstlane_b32 s36, v0
    s_load_dwordx2 s[28:29], s[0:1], 24
    s_load_dwordx2 s[12:13], s[0:1], 32
    v_and_b32 v192, 63, v0
    s_lshr_b32 s39, s2, 3
    s_lshr_b32 s36, s36, 6
    s_xor_b32 s36, s36, 4
    s_and_b32 s37, s36, 1
    s_lshr_b32 s38, s36, 1
    v_lshlrev_b32 v19, 4, v192
    s_mul_i32 s47, s36, 6432
    s_add_u32 s47, s47, 95232
    s_mov_b32 s31, 0x00020000
    s_mov_b32 s30, 1352
    s_cmp_ge_u32 s36, 4
    s_cselect_b64 vcc, -1, 0
    s_cbranch_scc1 L_g1
    s_setprio 2
    s_lshl_b32 s49, s36, 3
    s_lshr_b32 s49, 0x20000027, s49
    s_and_b32 s49, s49, 0xff
    s_lshl_b32 s49, s49, 4
    s_lshl_b32 s50, s36, 10
    s_add_u32 s50, s50, 17152
L_x:
    v_mul_u32_u24 v198, 5, v192
    s_and_b32 s40, s2, 7
    s_lshl2_add_u32 s40, s40, s38
    v_lshrrev_b32 v198, 6, v198
    s_mul_i32 s41, s39, 301056
    s_add_u32 s41, s41, 129024
    s_add_u32 s44, s41, 129024
    v_sub_u32 v198, v192, v198
    s_add_u32 s42, s41, 258048
    s_cmp_eq_u32 s39, 31
    s_cselect_b32 s42, 86016, s42
    v_lshlrev_b32 v198, 4, v198
    s_cmp_eq_u32 s37, 1
    s_cselect_b32 s41, s42, s41
    s_mov_b32 s43, 4294924288
    s_cselect_b32 s43, s43, 43008
    s_add_u32 s42, s41, s43
    s_add_u32 s43, s42, s43
    s_mul_i32 s45, s40, 1344
    s_add_u32 s45, s45, 576
    s_add_u32 s46, s45, 768
    s_cmp_eq_u32 s40, 31
    s_cselect_b32 s46, 0, s46
    s_mov_b32 s19, 0x00020000
    s_mov_b32 s18, 9633792
    s_mov_b32 s62, -1
    s_mov_b32 s63, 0xfffff
    s_mov_b32 s60, -1
    s_mov_b32 s61, 0x7f
    s_mov_b32 m0, s50
    s_waitcnt lgkmcnt(0)
    s_cbranch_vccnz L_x1
    buffer_load_dwordx4 v19, s[28:31], s49 offen lds
    s_mov_b64 s[28:29], s[12:13]
    s_load_dwordx2 s[24:25], s[0:1], 16
L_x1:
    s_mov_b64 exec, s[62:63]
    s_add_u32 m0, s47, 0
    s_add_u32 s54, s45, s41
    buffer_load_dwordx4 v198, s[16:19], s54 offen nt lds
    s_add_u32 m0, s47, 1616
    s_add_u32 s54, s45, s42
    buffer_load_dwordx4 v198, s[16:19], s54 offen nt lds
    s_add_u32 m0, s47, 3232
    s_add_u32 s54, s45, s43
    buffer_load_dwordx4 v198, s[16:19], s54 offen nt lds
    s_add_u32 m0, s47, 4848
    s_add_u32 s54, s45, s44
    buffer_load_dwordx4 v198, s[16:19], s54 offen nt lds
    s_mov_b64 exec, s[60:61]
    s_add_u32 m0, s47, 912
    s_add_u32 s54, s46, s41
    buffer_load_dwordx4 v198, s[16:19], s54 offen nt lds
    s_add_u32 m0, s47, 2528
    s_add_u32 s54, s46, s42
    buffer_load_dwordx4 v198, s[16:19], s54 offen nt lds
    s_add_u32 m0, s47, 4144
    s_add_u32 s54, s46, s43
    buffer_load_dwordx4 v198, s[16:19], s54 offen nt lds
    s_add_u32 m0, s47, 5760
    s_add_u32 s54, s46, s44
    buffer_load_dwordx4 v198, s[16:19], s54 offen nt lds
    s_mov_b64 exec, -1
L_x3:
    s_load_dwordx2 s[32:33], s[0:1], 48
    s_cbranch_vccnz L_g1r
    s_branch L_setup
L_g1:
    s_setprio 3
    s_load_dwordx2 s[24:25], s[0:1], 16
    v_mov_b32 v216, 0
    v_mov_b32 v217, 0
    v_lshlrev_b32 v199, 3, v192
    ds_write_b64 v199, v[216:217]
    v_lshrrev_b32 v200, 3, v192
    v_and_b32 v201, 7, v192
    v_mul_u32_u24 v200, 1152, v200
    v_lshl_add_u32 v205, v201, 4, v200
    s_mov_b32 s23, 0x00020000
    s_mov_b32 s22, 55296
    s_and_b32 s51, s36, 3
    s_lshl_b32 s49, s51, 10
    s_add_u32 s49, s49, 21504
    s_mul_i32 s50, s51, 9216
    s_and_b32 s51, s38, 1
    s_mul_i32 s52, s51, 9216
    s_lshl_b32 s51, s51, 10
    s_add_u32 s51, s51, 21504
    s_mul_i32 s53, s37, 24576
    s_add_u32 s53, s53, s51
    s_lshl_b32 s55, s37, 9
    s_add_u32 s55, s55, s52
    s_and_b32 s3, s36, 3
    s_lshl_b32 s3, s3, 2
    s_mov_b32 s27, 0x00020000
    s_mov_b32 s26, 18432
    s_waitcnt lgkmcnt(0)
    s_mov_b64 s[28:29], s[12:13]
    s_add_u32 m0, s49, 6144
    s_add_u32 s54, s50, 128
    buffer_load_dwordx4 v205, s[20:23], s54 offen lds
    s_add_u32 m0, s49, 0
    s_add_u32 s54, s50, 0
    buffer_load_dwordx4 v205, s[20:23], s54 offen lds
    s_add_u32 m0, s49, 24576
    s_add_u32 s54, s50, 512
    buffer_load_dwordx4 v205, s[20:23], s54 offen lds
    s_add_u32 m0, s49, 12288
    s_add_u32 s54, s50, 256
    buffer_load_dwordx4 v205, s[20:23], s54 offen lds
    s_add_u32 m0, s49, 30720
    s_add_u32 s54, s50, 640
    buffer_load_dwordx4 v205, s[20:23], s54 offen lds
    s_cmp_lg_u32 s36, 4
    s_cbranch_scc1 L_npf
    s_mul_i32 s54, s39, 2304
    v_lshl_add_u32 v206, v192, 7, s54
    s_mov_b64 exec, 0x3ffff
    s_cmp_ge_u32 s39, 24
    s_cbranch_scc1 L_pf2
    buffer_load_dword v220, v206, s[20:23], 0 offen
    s_branch L_pf3
L_pf2:
    v_subrev_u32 v206, 55296, v206
    buffer_load_dword v220, v206, s[24:27], 0 offen
L_pf3:
    s_mov_b64 exec, -1
L_npf:
    s_setprio 0
    s_branch L_setup
L_g1b:
    s_mov_b64 vcc, -1
    s_add_u32 m0, s49, 36864
    s_add_u32 s54, s50, 768
    buffer_load_dwordx4 v205, s[20:23], s54 offen lds
    s_add_u32 m0, s53, 4096
    s_add_u32 s54, s55, 36864
    buffer_load_dwordx4 v205, s[20:23], s54 offen lds
    s_add_u32 m0, s53, 10240
    s_add_u32 s54, s55, 36992
    buffer_load_dwordx4 v205, s[20:23], s54 offen lds
    s_add_u32 m0, s53, 16384
    s_add_u32 s54, s55, 37120
    buffer_load_dwordx4 v205, s[20:23], s54 offen lds
    s_mov_b64 exec, 1
    s_mov_b32 m0, s3
    s_nop 0
    buffer_load_dword off, s[28:31], 0 lds
    s_mov_b64 exec, -1
    s_branch L_x
L_g1r:
    s_xor_b32 s54, s36, 1
    s_mov_b64 exec, 1
    s_lshl2_add_u32 m0, s54, 96
    s_nop 0
    buffer_load_dword off, s[28:31], 0 lds
    s_mov_b64 exec, -1
    s_add_u32 m0, s49, 18432
    s_add_u32 s54, s50, 384
    buffer_load_dwordx4 v205, s[20:23], s54 offen lds
    s_add_u32 m0, s49, 43008
    s_add_u32 s54, s50, 896
    buffer_load_dwordx4 v205, s[20:23], s54 offen lds
    s_add_u32 m0, s49, 49152
    s_add_u32 s54, s50, 1024
    buffer_load_dwordx4 v205, s[20:23], s54 offen lds
    s_add_u32 m0, s53, 22528
    s_add_u32 s54, s55, 37248
    buffer_load_dwordx4 v205, s[20:23], s54 offen lds
    s_add_u32 m0, s51, 53248
    s_add_u32 s54, s52, 37888
    buffer_load_dwordx4 v205, s[20:23], s54 offen lds
    s_mov_b64 exec, 1
    s_add_u32 m0, s3, 32
    s_nop 0
    buffer_load_dword off, s[28:31], 0 lds
    s_mov_b64 exec, -1
    s_branch L_q3
L_setup:
    s_lshl_b32 s10, s36, 2
    v_mov_b32 v12, s10
    s_xor_b32 s10, s10, 4
    v_mov_b32 v199, 163840
    v_mov_b32 v200, s10
    v_cmp_eq_u32 vcc, 0, v192
    v_and_b32 v14, 7, v192
    v_mov_b32 v15, 1
    v_lshlrev_b32 v14, 2, v14
    v_cndmask_b32 v13, v199, v200, vcc
    v_and_b32 v193, 31, v192
    v_lshrrev_b32 v194, 5, v192
    v_bfe_u32 v195, v192, 4, 1
    v_bfe_u32 v196, v192, 2, 2
    v_and_b32 v197, 3, v192
    v_bfe_u32 v207, v192, 3, 2
    v_bfe_u32 v208, v192, 2, 1
    s_xor_b32 s48, s36, 1
    s_mul_i32 s48, s48, 6432
    s_add_u32 s48, s48, 95232
    v_cmp_eq_u32 s[4:5], 1, v208
    v_cmp_eq_u32 s[6:7], 3, v207
    v_add_u32 v199, 4, v207
    v_add_u32 v200, 3, v197
    v_cmp_lt_u32 s[8:9], 31, v192
    v_cndmask_b32 v210, v207, v197, s[4:5]
    v_cndmask_b32 v211, v197, v199, s[4:5]
    v_cndmask_b32 v212, v199, v200, s[4:5]
    v_cndmask_b32 v213, v200, v207, s[4:5]
    v_cndmask_b32 v210, v210, 3, s[6:7]
    v_cndmask_b32 v211, v211, 3, s[6:7]
    v_cndmask_b32 v212, v212, 3, s[6:7]
    v_cndmask_b32 v213, v213, 3, s[6:7]
    s_mul_i32 s10, s37, 6
    s_cmp_eq_u32 s37, 1
    s_cselect_b32 s11, -1, 1
    s_cselect_b64 s[12:13], -1, 0
    v_sub_u32 v228, 6, v211
    v_cndmask_b32 v228, v211, v228, s[12:13]
    v_sub_u32 v229, 6, v210
    v_cndmask_b32 v229, v210, v229, s[12:13]
    v_sub_u32 v230, 6, v213
    v_cndmask_b32 v230, v213, v230, s[12:13]
    v_sub_u32 v231, 6, v212
    v_cndmask_b32 v231, v212, v231, s[12:13]
    v_mul_u32_u24 v199, 208, v228
    v_cmp_lt_u32 vcc, 3, v228
    v_add_u32 v200, 80, v199
    s_nop 0
    v_cndmask_b32 v199, v199, v200, vcc
    v_mul_u32_u24 v200, 1616, v210
    v_lshl_add_u32 v199, v194, 4, v199
    v_add3_u32 v20, v199, v200, s47
    v_mul_u32_u24 v199, 208, v230
    v_cmp_lt_u32 vcc, 3, v230
    v_add_u32 v200, 80, v199
    s_nop 0
    v_cndmask_b32 v199, v199, v200, vcc
    v_sub_u32 v200, 6, v212
    v_mul_u32_u24 v200, 1616, v200
    v_lshl_add_u32 v199, v194, 4, v199
    v_mov_b32 v201, s47
    v_mov_b32 v202, s48
    v_cmp_eq_u32 vcc, 3, v212
    v_add_u32 v199, v199, v200
    s_nop 0
    v_cndmask_b32 v201, v202, v201, vcc
    v_add_u32 v21, v199, v201
    v_lshrrev_b32 v199, 1, v197
    v_lshl_add_u32 v199, v195, 1, v199
    v_lshlrev_b32 v199, 3, v199
    v_and_b32 v200, 1, v197
    v_lshlrev_b32 v200, 3, v200
    v_and_b32 v201, 1, v196
    v_mul_u32_u24 v201, 576, v201
    s_mul_i32 s10, s37, 48
    v_add3_u32 v200, v200, v201, s10
    v_lshrrev_b32 v201, 1, v196
    v_lshl_add_u32 v201, v194, 2, v201
    v_lshlrev_b32 v201, 7, v201
    v_add_u32 v201, 21504, v201
    s_mov_b32 s10, 0x000e0d0c
    v_lshrrev_b32 v202, v199, s10
    v_and_b32 v202, 0xff, v202
    v_lshl_add_u32 v202, v202, 4, v200
    v_lshrrev_b32 v203, 7, v202
    v_and_b32 v202, 127, v202
    v_mul_u32_u24 v203, 6144, v203
    v_add3_u32 v0, v202, v203, v201
    s_mov_b32 s10, 0x07060201
    v_lshrrev_b32 v202, v199, s10
    v_and_b32 v202, 0xff, v202
    v_lshl_add_u32 v202, v202, 4, v200
    v_lshrrev_b32 v203, 7, v202
    v_and_b32 v202, 127, v202
    v_mul_u32_u24 v203, 6144, v203
    v_add3_u32 v1, v202, v203, v201
    s_mov_b32 s10, 0x14131208
    v_lshrrev_b32 v202, v199, s10
    v_and_b32 v202, 0xff, v202
    v_lshl_add_u32 v202, v202, 4, v200
    v_lshrrev_b32 v203, 7, v202
    v_and_b32 v202, 127, v202
    v_mul_u32_u24 v203, 6144, v203
    v_add3_u32 v2, v202, v203, v201
    s_mov_b32 s10, 0x1b1a1918
    v_lshrrev_b32 v202, v199, s10
    v_and_b32 v202, 0xff, v202
    v_lshl_add_u32 v202, v202, 4, v200
    v_lshrrev_b32 v203, 7, v202
    v_and_b32 v202, 127, v202
    v_mul_u32_u24 v203, 6144, v203
    v_add3_u32 v3, v202, v203, v201
    s_mov_b32 s10, 0x21201f1e
    v_lshrrev_b32 v202, v199, s10
    v_and_b32 v202, 0xff, v202
    v_lshl_add_u32 v202, v202, 4, v200
    v_lshrrev_b32 v203, 7, v202
    v_and_b32 v202, 127, v202
    v_mul_u32_u24 v203, 6144, v203
    v_add3_u32 v4, v202, v203, v201
    v_lshl_add_u32 v201, v194, 2, v196
    v_mul_u32_u24 v201, 192, v201
    v_and_b32 v199, 1, v197
    v_lshl_add_u32 v201, v199, 5, v201
    v_lshl_add_u32 v201, v195, 4, v201
    v_lshrrev_b32 v199, 1, v197
    v_lshl_add_u32 v201, v199, 3, v201
    s_mul_i32 s10, s37, 4608
    s_add_u32 s10, s10, 76800
    v_add_u32 v5, s10, v201
    s_mul_i32 s14, s37, 9216
    s_sub_u32 s14, 4608, s14
    s_mul_i32 s10, s37, 4160
    s_add_u32 s10, s10, 1568
    v_mov_b32 v215, 160
    v_mul_u32_u24 v214, 2720, v194
    v_cndmask_b32 v232, v215, 16, s[8:9]
    v_cndmask_b32 v233, 16, v215, s[8:9]
    v_add_u32 v214, s10, v214
    v_mul_u32_u24 v215, 1280, v194
    v_mul_u32_u24 v199, v210, v232
    v_mul_u32_u24 v200, v212, v232
    v_sub_u32 v215, 688, v215
    v_mad_u32_u24 v199, v211, v233, v199
    v_mad_u32_u24 v200, v213, v233, v200
    v_sub_u32 v6, v214, v199
    v_sub_u32 v8, v214, v200
    v_add_u32 v7, v6, v215
    v_add_u32 v9, v8, v215
    s_barrier
    s_cmp_ge_u32 s36, 4
    s_cbranch_scc1 L_g1b
    s_xor_b32 s54, s36, 1
    s_mov_b64 exec, 1
    s_lshl2_add_u32 m0, s54, 96
    s_nop 0
    buffer_load_dword off, s[28:31], 0 lds
    s_mov_b64 exec, -1
L_q3:
    s_mul_i32 s10, s40, 7
    s_add_u32 s10, s10, 3
    s_mul_i32 s11, s39, 7
    s_add_u32 s11, s11, 3
    v_add_u32 v199, s10, v228
    v_add_u32 v200, s11, v229
    v_subrev_u32 v201, 224, v199
    v_subrev_u32 v202, 224, v200
    v_min_u32 v199, v199, v201
    v_min_u32 v200, v200, v202
    v_mul_u32_u24 v199, 192, v199
    v_mul_u32_u24 v200, 43008, v200
    v_mov_b32 v204, 0x80000000
    s_sub_u32 s10, 24, s37
    v_add_u32 v199, v199, v200
    v_cmp_lt_u32 vcc, s10, v193
    v_lshrrev_b32 v202, 4, v192
    v_lshlrev_b32 v202, 4, v202
    v_cndmask_b32 v199, v199, v204, vcc
    s_mov_b32 s35, 0x00020000
    s_mov_b32 s34, 9633792
    v_mov_b32 v200, v199
    s_nop 1
    v_permlane16_swap_b32 v199, v200
    v_add_u32 v10, v199, v202
    v_add_u32 v11, v200, v202
    v_lshl_add_u32 v17, v192, 3, s47
    v_xor_b32 v199, 3, v192
    v_lshlrev_b32 v200, 4, v207
    v_sub_u32 v199, v199, v200
    v_add_u32 v199, 16, v199
    v_lshlrev_b32 v200, 5, v194
    v_add_u32 v200, 24, v200
    v_cndmask_b32 v199, v199, v200, s[6:7]
    v_lshl_add_u32 v18, v199, 3, s48
    v_mov_b32 v23, 0
    s_cmp_eq_u32 s39, 31
    s_cselect_b32 s10, 3, 99
    s_cmp_eq_u32 s40, 31
    s_cselect_b32 s11, 3, 99
    s_mov_b32 s56, 0x3f80
    s_mov_b32 s57, 0
    s_mov_b32 s58, 0xffff
    s_mov_b32 s59, 0
    v_mov_b32 v203, 0xc3f5c3f5
    v_cmp_lt_u32 vcc, 24, v193
    v_mov_b32 v199, 0xff00
    v_mov_b32 v214, 0x3f80
    v_cndmask_b32 v215, 0, v199, vcc
    v_cmp_lt_u32 vcc, s10, v229
    v_cmp_lt_u32 s[12:13], s11, v228
    s_nop 0
    v_cndmask_b32 v199, 0, 32, vcc
    v_cndmask_b32 v200, 0, 16, s[12:13]
    v_add_u32 v199, v199, v200
    v_lshlrev_b64 v[232:233], v199, s[56:57]
    v_lshlrev_b64 v[234:235], v199, s[58:59]
    v_cndmask_b32 v144, v232, v214, s[8:9]
    v_cndmask_b32 v145, v233, 0, s[8:9]
    v_bfi_b32 v234, v234, 0, v203
    v_bfi_b32 v235, v235, 0, v203
    v_cndmask_b32 v168, v234, v215, s[8:9]
    v_cndmask_b32 v169, v235, 0, s[8:9]
    v_cmp_lt_u32 vcc, s10, v231
    v_cmp_lt_u32 s[12:13], s11, v230
    s_nop 0
    v_cndmask_b32 v199, 0, 32, vcc
    v_cndmask_b32 v200, 0, 16, s[12:13]
    v_add_u32 v199, v199, v200
    v_lshlrev_b64 v[232:233], v199, s[56:57]
    v_lshlrev_b64 v[234:235], v199, s[58:59]
    v_cndmask_b32 v152, v232, v214, s[8:9]
    v_cndmask_b32 v153, v233, 0, s[8:9]
    v_bfi_b32 v234, v234, 0, v203
    v_bfi_b32 v235, v235, 0, v203
    v_cndmask_b32 v176, v234, v215, s[8:9]
    v_cndmask_b32 v177, v235, 0, s[8:9]
    v_mov_b32 v160, v152
    v_mov_b32 v161, v153
    v_mov_b32 v178, 0x3f803f80
    v_mov_b32 v179, 0x3f803f80
    v_mov_b32 v180, 0x3f803f80
    v_mov_b32 v181, 0x3f803f80
    v_mov_b32 v182, 0x3f803f80
    v_mov_b32 v183, 0x3f803f80
    v_mov_b32 v184, 0x3f803f80
    v_mov_b32 v185, 0x3f803f80
    v_mov_b32 v186, 0x3f803f80
    v_mov_b32 v187, 0x3f803f80
    v_mov_b32 v188, 0x3f803f80
    v_mov_b32 v189, 0x3f803f80
    v_mov_b32 v190, 0x3f803f80
    v_mov_b32 v191, 0x3f803f80
    s_mov_b32 s56, 0x00ffffff
    s_mov_b32 s57, 0x00ffffff
    s_mov_b32 s58, -1
    s_mov_b32 s59, 0
    s_setprio 0
    s_cmp_ge_u32 s36, 4
    s_cbranch_scc1 L_main
    s_setprio 2
    s_lshl_b32 s54, s37, 6
    s_add_u32 s54, s54, 1
    v_add_u32 v207, s54, v192
    s_cmp_eq_u32 s38, 1
    s_movk_i32 s8, 205
    s_cmovk_i32 s8, 158
    s_cselect_b32 s9, 0, -184
    s_cselect_b32 s10, 0, 1248
    v_mul_u32_u24 v209, s8, v207
    s_sub_u32 s50, s50, s49
    s_add_u32 s10, s10, s50
    v_lshl_add_u32 v201, v207, 3, s10
    v_lshrrev_b32 v209, 11, v209
    s_cmp_eq_u32 s38, 1
    s_cselect_b32 s8, 160, 16
    v_mad_i32_i24 v201, v209, s9, v201
    s_movk_i32 s9, -320
    s_cmovk_i32 s9, -2064
    s_movk_i32 s10, 1920
    s_cmovk_i32 s10, 2080
    s_movk_i32 s11, 2064
    s_cmovk_i32 s11, 6224
    v_mul_u32_u24 v199, s8, v207
    s_waitcnt vmcnt(9)
    s_cbranch_scc1 L_bv
    ds_read2_b64 v[220:223], v201 offset1:1
    ds_read2_b64 v[224:227], v201 offset0:2 offset1:3
    s_branch L_bw
L_bv:
    s_waitcnt lgkmcnt(1)
    ds_read2_b64 v[220:223], v201 offset1:13
    s_waitcnt lgkmcnt(1)
    ds_read2_b64 v[224:227], v201 offset0:26 offset1:39
L_bw:
    v_mad_i32_i24 v199, v209, s9, v199
    s_mov_b32 s8, 0x409cc471
    s_mov_b32 s9, 0x409cc471
    v_add_u32 v199, s10, v199
    v_sub_u32 v200, s11, v199
    s_waitcnt lgkmcnt(0)
    v_lshlrev_b32 v231, 16, v220
    v_and_b32 v232, 0xffff0000, v220
    v_lshlrev_b32 v239, 16, v221
    v_and_b32 v240, 0xffff0000, v221
    v_lshlrev_b32 v230, 16, v222
    v_and_b32 v233, 0xffff0000, v222
    v_lshlrev_b32 v238, 16, v223
    v_and_b32 v241, 0xffff0000, v223
    v_lshlrev_b32 v229, 16, v224
    v_and_b32 v234, 0xffff0000, v224
    v_lshlrev_b32 v237, 16, v225
    v_and_b32 v242, 0xffff0000, v225
    v_lshlrev_b32 v228, 16, v226
    v_and_b32 v235, 0xffff0000, v226
    v_lshlrev_b32 v236, 16, v227
    v_and_b32 v243, 0xffff0000, v227
    v_pk_mul_f32 v[228:229], v[228:229], s[8:9]
    v_pk_mul_f32 v[230:231], v[230:231], s[8:9]
    v_pk_mul_f32 v[232:233], v[232:233], s[8:9]
    v_pk_mul_f32 v[234:235], v[234:235], s[8:9]
    ds_write_b128 v200, v[228:231] offset:512
    v_pk_mul_f32 v[236:237], v[236:237], s[8:9]
    v_pk_mul_f32 v[238:239], v[238:239], s[8:9]
    ds_write_b128 v199, v[232:235] offset:4672
    v_pk_mul_f32 v[240:241], v[240:241], s[8:9]
    v_pk_mul_f32 v[242:243], v[242:243], s[8:9]
    ds_write_b128 v200, v[236:239] offset:8832
    ds_write_b128 v199, v[240:243] offset:12992
    s_mov_b64 exec, 1
    ds_write_b32 v12, v15 offset:16
    s_mov_b64 exec, -1
L_main:
    s_mov_b32 s27, 0x00020000
    s_mov_b32 s26, 18432
    s_mul_i32 s15, s36, 2304
    s_add_u32 s52, s15, 76800
    s_lshl2_add_u32 s53, s36, 48
    v_mov_b32 v204, 0
    v_mov_b32 v236, 0
    s_waitcnt lgkmcnt(0)
    s_nop 1
    s_setprio 2
    ds_read_b32 v24, v14 offset:0
    ds_read_b64_tr_b16 v[74:75], v0 offset:0
    ds_read_b64_tr_b16 v[76:77], v0 offset:256
    ds_read_b64_tr_b16 v[78:79], v0 offset:1024
    ds_read_b64_tr_b16 v[80:81], v0 offset:1280
    ds_read_b64_tr_b16 v[82:83], v0 offset:2048
    ds_read_b64_tr_b16 v[84:85], v0 offset:2304
    ds_read_b64_tr_b16 v[86:87], v0 offset:3072
    ds_read_b64_tr_b16 v[88:89], v0 offset:3328
    ds_read_b64_tr_b16 v[90:91], v0 offset:4096
    ds_read_b64_tr_b16 v[92:93], v0 offset:4352
    ds_read_b64_tr_b16 v[94:95], v0 offset:5120
    ds_read_b64_tr_b16 v[96:97], v0 offset:5376
    ds_read_b64_tr_b16 v[98:99], v1 offset:0
    ds_read_b64_tr_b16 v[100:101], v1 offset:256
    ds_read_b64_tr_b16 v[102:103], v1 offset:1024
    ds_read_b64_tr_b16 v[104:105], v1 offset:1280
    s_waitcnt lgkmcnt(15)
    v_cmp_eq_u32 vcc, 0, v24
    s_cbranch_vccnz L_zea
L_kea:
    s_waitcnt vmcnt(6)
    s_cmp_ge_u32 s36, 4
    s_cbranch_scc1 L_xw
    s_waitcnt vmcnt(0)
L_xw:
    ds_read_b128 v[26:29], v20 offset:0
    ds_read_b128 v[30:33], v20 offset:32
    ds_read_b128 v[34:37], v20 offset:64
    ds_read_b128 v[38:41], v20 offset:96
    ds_read_b128 v[42:45], v20 offset:128
    ds_read_b128 v[46:49], v20 offset:160
    ds_read_b32 v25, v12 offset:96
    s_waitcnt lgkmcnt(6)
    v_mfma_f32_32x32x16_bf16 v[106:121], v[74:77], v[26:29], 0
    ds_read_b128 v[50:53], v21 offset:0
    ds_read_b128 v[54:57], v21 offset:32
    s_waitcnt lgkmcnt(2)
    v_cmp_eq_u32 vcc, 0, v25
    v_mfma_f32_32x32x16_bf16 v[106:121], v[78:81], v[30:33], v[106:121]
    ds_read_b128 v[58:61], v21 offset:64
    ds_read_b128 v[62:65], v21 offset:96
    s_cbranch_vccnz L_zc1
L_kc1:
    v_mfma_f32_32x32x16_bf16 v[106:121], v[82:85], v[34:37], v[106:121]
    ds_read_b128 v[66:69], v21 offset:128
    ds_read_b128 v[70:73], v21 offset:160
    v_mfma_f32_32x32x16_bf16 v[106:121], v[86:89], v[38:41], v[106:121]
    v_mfma_f32_32x32x16_bf16 v[106:121], v[90:93], v[42:45], v[106:121]
    v_mfma_f32_32x32x16_bf16 v[106:121], v[94:97], v[46:49], v[106:121]
    s_waitcnt lgkmcnt(3)
    v_mfma_f32_32x32x16_bf16 v[122:137], v[74:77], v[50:53], 0
    ds_read_b64_tr_b16 v[74:75], v1 offset:2048
    ds_read_b64_tr_b16 v[76:77], v1 offset:2304
    ds_read_b128 v[192:195], v8 offset:0
    v_add_u32 v0, s14, v5
    v_mfma_f32_32x32x16_bf16 v[122:137], v[78:81], v[54:57], v[122:137]
    ds_read_b64_tr_b16 v[78:79], v1 offset:3072
    ds_read_b64_tr_b16 v[80:81], v1 offset:3328
    s_nop 2
    v_cvt_pk_bf16_f32 v162, v106, v107
    v_mfma_f32_32x32x16_bf16 v[122:137], v[82:85], v[58:61], v[122:137]
    ds_read_b64_tr_b16 v[82:83], v1 offset:4096
    ds_read_b64_tr_b16 v[84:85], v1 offset:4352
    ds_read_b128 v[196:199], v8 offset:160
    v_cvt_pk_bf16_f32 v163, v108, v109
    v_cvt_pk_bf16_f32 v164, v110, v111
    s_waitcnt lgkmcnt(8)
    v_mfma_f32_32x32x16_bf16 v[122:137], v[86:89], v[62:65], v[122:137]
    ds_read_b64_tr_b16 v[86:87], v1 offset:5120
    ds_read_b64_tr_b16 v[88:89], v1 offset:5376
    v_cvt_pk_bf16_f32 v165, v112, v113
    v_cvt_pk_bf16_f32 v166, v114, v115
    v_cvt_pk_bf16_f32 v167, v116, v117
    v_cvt_pk_bf16_f32 v138, v118, v119
    v_mfma_f32_32x32x16_bf16 v[122:137], v[90:93], v[66:69], v[122:137]
    ds_read_b128 v[200:203], v8 offset:320
    v_cvt_pk_bf16_f32 v139, v120, v121
    v_mfma_f32_32x32x16_bf16 v[122:137], v[94:97], v[70:73], v[122:137]
    s_mov_b64 exec, s[58:59]
    ds_read_b32 v204, v8 offset:492
    s_mov_b64 exec, -1
    v_mfma_f32_32x32x16_bf16 v[106:121], v[98:101], v[50:53], 0
    s_setprio 3
    ds_read_b128 v[208:211], v9 offset:0
    v_mfma_f32_32x32x16_bf16 v[106:121], v[102:105], v[54:57], v[106:121]
    s_waitcnt lgkmcnt(4)
    v_mfma_f32_32x32x16_bf16 v[106:121], v[74:77], v[58:61], v[106:121]
    ds_read_b128 v[212:215], v9 offset:160
    s_nop 1
    v_cvt_pk_bf16_f32 v170, v122, v123
    v_cvt_pk_bf16_f32 v171, v124, v125
    v_mfma_f32_32x32x16_bf16 v[106:121], v[78:81], v[62:65], v[106:121]
    v_cvt_pk_bf16_f32 v172, v126, v127
    v_cvt_pk_bf16_f32 v173, v128, v129
    v_cvt_pk_bf16_f32 v174, v130, v131
    v_cvt_pk_bf16_f32 v175, v132, v133
    v_cvt_pk_bf16_f32 v154, v134, v135
    v_cvt_pk_bf16_f32 v155, v136, v137
    v_mfma_f32_32x32x16_bf16 v[106:121], v[82:85], v[66:69], v[106:121]
    ds_read_b128 v[216:219], v9 offset:320
    s_waitcnt lgkmcnt(2)
    v_mfma_f32_32x32x16_bf16 v[106:121], v[86:89], v[70:73], v[106:121]
    v_mfma_f32_32x32x16_bf16 v[122:137], v[98:101], v[26:29], 0
    v_mfma_f32_32x32x16_bf16 v[122:137], v[102:105], v[30:33], v[122:137]
    v_mfma_f32_32x32x16_bf16 v[122:137], v[74:77], v[34:37], v[122:137]
    s_nop 8
    v_cvt_pk_bf16_f32 v156, v106, v107
    v_cvt_pk_bf16_f32 v157, v108, v109
    v_cvt_pk_bf16_f32 v158, v110, v111
    v_cvt_pk_bf16_f32 v159, v112, v113
    v_mfma_f32_32x32x16_bf16 v[192:207], v[162:165], v[154:157], v[192:207]
    v_cvt_pk_bf16_f32 v146, v114, v115
    v_cvt_pk_bf16_f32 v147, v116, v117
    v_cvt_pk_bf16_f32 v148, v118, v119
    v_cvt_pk_bf16_f32 v149, v120, v121
    v_mfma_f32_32x32x16_bf16 v[192:207], v[166:169], v[158:161], v[192:207]
    s_waitcnt lgkmcnt(0)
    v_mfma_f32_32x32x16_bf16 v[208:223], v[170:173], v[154:157], v[208:223]
    v_mfma_f32_32x32x16_bf16 v[208:223], v[174:177], v[158:161], v[208:223]
    s_setprio 0
    s_mov_b32 m0, s52
    s_nop 0
    buffer_load_dwordx4 v19, s[24:27], s15 offen lds
    buffer_load_dwordx4 v19, s[24:27], s15 offen offset:1024 lds
    s_mov_b64 exec, 0xffff
    buffer_load_dwordx4 v19, s[24:27], s15 offen offset:2048 lds
    s_mov_b64 exec, 1
    s_mov_b32 m0, s53
    s_nop 0
    buffer_load_dword off, s[28:31], 0 lds
    s_mov_b64 exec, -1
    v_max3_f32 v220, v192, v193, v194
    v_max3_f32 v220, v220, v195, v196
    v_max3_f32 v220, v220, v197, v198
    v_max3_f32 v220, v220, v199, v200
    v_max3_f32 v220, v220, v201, v202
    v_max3_f32 v220, v220, v203, v204
    v_max3_f32 v220, v220, v208, v209
    v_max3_f32 v220, v220, v210, v211
    v_max3_f32 v220, v220, v212, v213
    v_max3_f32 v220, v220, v214, v215
    v_max3_f32 v220, v220, v216, v217
    v_max3_f32 v220, v220, v218, v219
    v_mov_b32 v221, v220
    s_nop 1
    v_permlane32_swap_b32 v221, v220
    v_max_f32 v220, v220, v221
    v_mul_f32 v220, 0xbe96c740, v220
    v_fmamk_f32 v192, v192, 0x3e96c740, v220
    v_exp_f32 v192, v192
    v_fmamk_f32 v193, v193, 0x3e96c740, v220
    v_exp_f32 v193, v193
    v_fmamk_f32 v194, v194, 0x3e96c740, v220
    v_exp_f32 v194, v194
    s_setprio 1
    v_fmamk_f32 v195, v195, 0x3e96c740, v220
    v_exp_f32 v195, v195
    v_fmamk_f32 v196, v196, 0x3e96c740, v220
    v_exp_f32 v196, v196
    v_fmamk_f32 v197, v197, 0x3e96c740, v220
    v_exp_f32 v197, v197
    v_fmamk_f32 v198, v198, 0x3e96c740, v220
    v_exp_f32 v198, v198
    v_fmamk_f32 v199, v199, 0x3e96c740, v220
    v_exp_f32 v199, v199
    v_fmamk_f32 v200, v200, 0x3e96c740, v220
    v_exp_f32 v200, v200
    v_fmamk_f32 v201, v201, 0x3e96c740, v220
    v_exp_f32 v201, v201
    v_fmamk_f32 v202, v202, 0x3e96c740, v220
    v_exp_f32 v202, v202
    v_fmamk_f32 v203, v203, 0x3e96c740, v220
    v_exp_f32 v203, v203
    v_fmamk_f32 v204, v204, 0x3e96c740, v220
    v_exp_f32 v204, v204
    v_fmamk_f32 v208, v208, 0x3e96c740, v220
    v_exp_f32 v208, v208
    v_fmamk_f32 v209, v209, 0x3e96c740, v220
    v_exp_f32 v209, v209
    v_fmamk_f32 v210, v210, 0x3e96c740, v220
    v_exp_f32 v210, v210
    v_fmamk_f32 v211, v211, 0x3e96c740, v220
    v_exp_f32 v211, v211
    v_fmamk_f32 v212, v212, 0x3e96c740, v220
    v_exp_f32 v212, v212
    v_fmamk_f32 v213, v213, 0x3e96c740, v220
    v_exp_f32 v213, v213
    v_fmamk_f32 v214, v214, 0x3e96c740, v220
    v_exp_f32 v214, v214
    v_fmamk_f32 v215, v215, 0x3e96c740, v220
    v_exp_f32 v215, v215
    v_fmamk_f32 v216, v216, 0x3e96c740, v220
    v_exp_f32 v216, v216
    v_fmamk_f32 v217, v217, 0x3e96c740, v220
    v_exp_f32 v217, v217
    v_fmamk_f32 v218, v218, 0x3e96c740, v220
    v_exp_f32 v218, v218
    v_fmamk_f32 v219, v219, 0x3e96c740, v220
    v_cvt_pk_bf16_f32 v192, v192, v193
    v_exp_f32 v219, v219
    s_setprio 3
    ds_read_b32 v24, v14 offset:16
    ds_read_b64_tr_b16 v[90:91], v3 offset:0
    ds_read_b64_tr_b16 v[92:93], v3 offset:256
    ds_read_b64_tr_b16 v[94:95], v3 offset:1024
    ds_read_b64_tr_b16 v[96:97], v3 offset:1280
    ds_read_b64_tr_b16 v[98:99], v3 offset:2048
    ds_read_b64_tr_b16 v[100:101], v3 offset:2304
    ds_read_b64_tr_b16 v[102:103], v3 offset:3072
    ds_read_b64_tr_b16 v[104:105], v3 offset:3328
    ds_read_b64_tr_b16 v[74:75], v3 offset:4096
    ds_read_b64_tr_b16 v[76:77], v3 offset:4352
    s_setprio 1
    v_cvt_pk_bf16_f32 v193, v194, v195
    v_cvt_pk_bf16_f32 v194, v196, v197
    v_cvt_pk_bf16_f32 v195, v198, v199
    v_cvt_pk_bf16_f32 v196, v200, v201
    v_cvt_pk_bf16_f32 v197, v202, v203
    v_cvt_pk_bf16_f32 v22, v204, 0
    v_cvt_pk_bf16_f32 v200, v208, v209
    v_cvt_pk_bf16_f32 v201, v210, v211
    v_cvt_pk_bf16_f32 v202, v212, v213
    v_cvt_pk_bf16_f32 v203, v214, v215
    v_cvt_pk_bf16_f32 v198, v216, v217
    v_cvt_pk_bf16_f32 v199, v218, v219
    s_setprio 2
    v_mfma_f32_32x32x16_bf16 v[122:137], v[78:81], v[38:41], v[122:137]
    ds_read_b64_tr_b16 v[78:79], v3 offset:5120
    ds_read_b64_tr_b16 v[80:81], v3 offset:5376
    s_waitcnt lgkmcnt(12)
    v_cmp_eq_u32 vcc, 0, v24
    s_mov_b64 exec, s[58:59]
    ds_read_b32 v236, v6 offset:492
    s_mov_b64 exec, -1
    v_mfma_f32_32x32x16_bf16 v[122:137], v[82:85], v[42:45], v[122:137]
    ds_read_b64_tr_b16 v[82:83], v2 offset:0
    ds_read_b64_tr_b16 v[84:85], v2 offset:256
    s_cbranch_vccnz L_zed
L_ked:
    ds_read_b128 v[224:227], v6 offset:0
    ds_read_b128 v[228:231], v6 offset:160
    v_mfma_f32_32x32x16_bf16 v[122:137], v[86:89], v[46:49], v[122:137]
    ds_read_b64_tr_b16 v[86:87], v2 offset:1024
    ds_read_b64_tr_b16 v[88:89], v2 offset:1280
    ds_read_b128 v[232:235], v6 offset:320
    ds_read_b128 v[240:243], v7 offset:0
    ds_read_b128 v[244:247], v7 offset:160
    s_waitcnt lgkmcnt(12)
    v_mfma_f32_32x32x16_bf16 v[106:121], v[26:29], v[90:93], 0
    ds_read_b128 v[248:251], v7 offset:320
    s_mov_b64 exec, s[58:59]
    ds_read_b32 v204, v8 offset:8812
    s_mov_b64 exec, -1
    s_nop 0
    v_cvt_pk_bf16_f32 v140, v122, v123
    v_mfma_f32_32x32x16_bf16 v[106:121], v[30:33], v[94:97], v[106:121]
    v_cvt_pk_bf16_f32 v141, v124, v125
    v_cvt_pk_bf16_f32 v142, v126, v127
    v_cvt_pk_bf16_f32 v143, v128, v129
    v_cvt_pk_bf16_f32 v154, v130, v131
    v_cvt_pk_bf16_f32 v155, v132, v133
    v_cvt_pk_bf16_f32 v156, v134, v135
    v_mfma_f32_32x32x16_bf16 v[106:121], v[34:37], v[98:101], v[106:121]
    v_cvt_pk_bf16_f32 v157, v136, v137
    v_mov_b32 v160, v144
    v_mov_b32 v161, v145
    v_mfma_f32_32x32x16_bf16 v[106:121], v[38:41], v[102:105], v[106:121]
    v_mfma_f32_32x32x16_bf16 v[106:121], v[42:45], v[74:77], v[106:121]
    s_waitcnt lgkmcnt(1)
    v_mfma_f32_32x32x16_bf16 v[106:121], v[46:49], v[78:81], v[106:121]
    v_mfma_f32_32x32x16_bf16 v[122:137], v[50:53], v[90:93], 0
    ds_read_b64_tr_b16 v[90:91], v2 offset:2048
    ds_read_b64_tr_b16 v[92:93], v2 offset:2304
    v_mfma_f32_32x32x16_bf16 v[122:137], v[54:57], v[94:97], v[122:137]
    ds_read_b64_tr_b16 v[94:95], v2 offset:3072
    ds_read_b64_tr_b16 v[96:97], v2 offset:3328
    v_mfma_f32_32x32x16_bf16 v[122:137], v[58:61], v[98:101], v[122:137]
    s_setprio 3
    ds_read_b64_tr_b16 v[98:99], v2 offset:4096
    ds_read_b64_tr_b16 v[100:101], v2 offset:4352
    s_mov_b64 exec, s[56:57]
    s_nop 0
    v_cvt_pk_bf16_f32 v178, v106, v107
    v_cvt_pk_bf16_f32 v179, v108, v109
    v_cvt_pk_bf16_f32 v180, v110, v111
    v_cvt_pk_bf16_f32 v181, v112, v113
    s_mov_b64 exec, -1
    v_mfma_f32_32x32x16_bf16 v[122:137], v[62:65], v[102:105], v[122:137]
    ds_read_b64_tr_b16 v[102:103], v2 offset:5120
    ds_read_b64_tr_b16 v[104:105], v2 offset:5376
    s_mov_b64 exec, s[56:57]
    v_cvt_pk_bf16_f32 v186, v114, v115
    v_cvt_pk_bf16_f32 v187, v116, v117
    v_cvt_pk_bf16_f32 v190, v118, v119
    s_mov_b64 exec, -1
    v_mfma_f32_32x32x16_bf16 v[122:137], v[66:69], v[74:77], v[122:137]
    ds_read_b64_tr_b16 v[74:75], v4 offset:0
    ds_read_b64_tr_b16 v[76:77], v4 offset:256
    v_mfma_f32_32x32x16_bf16 v[122:137], v[70:73], v[78:81], v[122:137]
    ds_read_b64_tr_b16 v[78:79], v4 offset:1024
    ds_read_b64_tr_b16 v[80:81], v4 offset:1280
    v_mfma_f32_32x32x16_bf16 v[224:239], v[162:165], v[138:141], v[224:239]
    v_mfma_f32_32x32x16_bf16 v[224:239], v[166:169], v[142:145], v[224:239]
    v_mfma_f32_32x32x16_bf16 v[240:255], v[170:173], v[138:141], v[240:255]
    v_mfma_f32_32x32x16_bf16 v[240:255], v[174:177], v[142:145], v[240:255]
    v_mfma_f32_32x32x16_bf16 v[208:223], v[178:181], v[192:195], 0
    ds_read_b128 v[192:195], v8 offset:8320
    s_mov_b64 exec, s[56:57]
    s_nop 2
    v_cvt_pk_bf16_f32 v182, v122, v123
    v_cvt_pk_bf16_f32 v183, v124, v125
    v_cvt_pk_bf16_f32 v184, v126, v127
    v_cvt_pk_bf16_f32 v185, v128, v129
    s_mov_b64 exec, -1
    v_mfma_f32_32x32x8_bf16 v[208:223], v[190:191], v[22:23], v[208:223]
    s_mov_b64 exec, s[56:57]
    v_cvt_pk_bf16_f32 v188, v130, v131
    v_cvt_pk_bf16_f32 v189, v132, v133
    s_mov_b64 exec, -1
    v_mfma_f32_32x32x16_bf16 v[208:223], v[182:185], v[200:203], v[208:223]
    ds_read_b128 v[200:203], v8 offset:8640
    v_max3_f32 v252, v224, v225, v226
    v_max3_f32 v252, v252, v227, v228
    v_max3_f32 v252, v252, v229, v230
    v_mfma_f32_32x32x16_bf16 v[208:223], v[186:189], v[196:199], v[208:223]
    ds_read_b128 v[196:199], v8 offset:8480
    s_setprio 0
    v_max3_f32 v252, v252, v231, v232
    v_max3_f32 v252, v252, v233, v234
    v_max3_f32 v252, v252, v235, v236
    v_max3_f32 v252, v252, v240, v241
    v_max3_f32 v252, v252, v242, v243
    v_max3_f32 v252, v252, v244, v245
    v_max3_f32 v252, v252, v246, v247
    v_max3_f32 v252, v252, v248, v249
    v_max3_f32 v252, v252, v250, v251
    v_mov_b32 v253, v252
    s_nop 1
    v_permlane32_swap_b32 v253, v252
    v_max_f32 v252, v252, v253
    v_mul_f32 v252, 0xbe96c740, v252
    v_fmamk_f32 v224, v224, 0x3e96c740, v252
    v_exp_f32 v224, v224
    v_fmamk_f32 v225, v225, 0x3e96c740, v252
    v_exp_f32 v225, v225
    v_fmamk_f32 v226, v226, 0x3e96c740, v252
    v_exp_f32 v226, v226
    v_fmamk_f32 v227, v227, 0x3e96c740, v252
    v_exp_f32 v227, v227
    v_fmamk_f32 v228, v228, 0x3e96c740, v252
    v_exp_f32 v228, v228
    v_fmamk_f32 v229, v229, 0x3e96c740, v252
    v_exp_f32 v229, v229
    v_fmamk_f32 v230, v230, 0x3e96c740, v252
    v_exp_f32 v230, v230
    s_setprio 1
    v_fmamk_f32 v231, v231, 0x3e96c740, v252
    v_exp_f32 v231, v231
    v_fmamk_f32 v232, v232, 0x3e96c740, v252
    v_exp_f32 v232, v232
    v_fmamk_f32 v233, v233, 0x3e96c740, v252
    v_exp_f32 v233, v233
    v_fmamk_f32 v234, v234, 0x3e96c740, v252
    v_exp_f32 v234, v234
    v_fmamk_f32 v235, v235, 0x3e96c740, v252
    v_exp_f32 v235, v235
    v_fmamk_f32 v236, v236, 0x3e96c740, v252
    v_exp_f32 v236, v236
    v_fmamk_f32 v240, v240, 0x3e96c740, v252
    v_exp_f32 v240, v240
    v_fmamk_f32 v241, v241, 0x3e96c740, v252
    v_exp_f32 v241, v241
    v_fmamk_f32 v242, v242, 0x3e96c740, v252
    v_exp_f32 v242, v242
    v_fmamk_f32 v243, v243, 0x3e96c740, v252
    v_exp_f32 v243, v243
    v_fmamk_f32 v244, v244, 0x3e96c740, v252
    v_exp_f32 v244, v244
    v_fmamk_f32 v245, v245, 0x3e96c740, v252
    v_exp_f32 v245, v245
    v_fmamk_f32 v246, v246, 0x3e96c740, v252
    v_exp_f32 v246, v246
    v_fmamk_f32 v247, v247, 0x3e96c740, v252
    v_exp_f32 v247, v247
    v_fmamk_f32 v248, v248, 0x3e96c740, v252
    v_exp_f32 v248, v248
    v_fmamk_f32 v249, v249, 0x3e96c740, v252
    v_exp_f32 v249, v249
    v_fmamk_f32 v250, v250, 0x3e96c740, v252
    v_exp_f32 v250, v250
    v_fmamk_f32 v251, v251, 0x3e96c740, v252
    v_rcp_f32 v221, v220
    v_cvt_pk_bf16_f32 v224, v224, v225
    v_exp_f32 v251, v251
    v_cvt_pk_bf16_f32 v225, v226, v227
    v_cvt_pk_bf16_f32 v226, v228, v229
    v_mul_f32 v208, v208, v221
    v_mul_f32 v209, v209, v221
    v_cvt_pk_bf16_f32 v227, v230, v231
    v_cvt_pk_bf16_f32 v228, v232, v233
    v_cvt_pk_bf16_f32 v229, v234, v235
    v_mul_f32 v210, v210, v221
    v_mul_f32 v211, v211, v221
    v_cvt_pk_bf16_f32 v208, v208, v209
    v_cvt_pk_bf16_f32 v22, v236, 0
    v_cvt_pk_bf16_f32 v232, v240, v241
    v_cvt_pk_bf16_f32 v233, v242, v243
    v_cvt_pk_bf16_f32 v234, v244, v245
    v_cvt_pk_bf16_f32 v235, v246, v247
    v_cvt_pk_bf16_f32 v230, v248, v249
    v_cvt_pk_bf16_f32 v231, v250, v251
    v_mul_f32 v212, v212, v221
    v_mul_f32 v213, v213, v221
    v_cvt_pk_bf16_f32 v209, v210, v211
    v_mul_f32 v214, v214, v221
    v_mul_f32 v215, v215, v221
    v_mul_f32 v216, v216, v221
    v_mul_f32 v217, v217, v221
    v_mul_f32 v218, v218, v221
    v_mul_f32 v219, v219, v221
    v_cvt_pk_bf16_f32 v210, v212, v213
    v_cvt_pk_bf16_f32 v211, v214, v215
    v_cvt_pk_bf16_f32 v212, v216, v217
    v_cvt_pk_bf16_f32 v213, v218, v219
    s_setprio 2
    v_mfma_f32_32x32x16_bf16 v[106:121], v[82:85], v[50:53], 0
    ds_read_b128 v[216:219], v9 offset:8640
    s_mov_b64 exec, s[58:59]
    ds_read_b32 v236, v6 offset:8812
    s_mov_b64 exec, -1
    ds_write_b64 v17, v[208:209] offset:4848
    v_mfma_f32_32x32x16_bf16 v[106:121], v[86:89], v[54:57], v[106:121]
    ds_write_b64 v17, v[210:211] offset:5360
    ds_read_b128 v[208:211], v9 offset:8320
    s_waitcnt lgkmcnt(5)
    v_mfma_f32_32x32x16_bf16 v[106:121], v[90:93], v[58:61], v[106:121]
    ds_write_b64 v17, v[212:213] offset:5872
    ds_read_b128 v[212:215], v9 offset:8480
    v_mfma_f32_32x32x16_bf16 v[106:121], v[94:97], v[62:65], v[106:121]
    ds_add_u32 v13, v15 offset:128
    v_mfma_f32_32x32x16_bf16 v[106:121], v[98:101], v[66:69], v[106:121]
    v_mfma_f32_32x32x16_bf16 v[106:121], v[102:105], v[70:73], v[106:121]
    v_mfma_f32_32x32x16_bf16 v[122:137], v[82:85], v[26:29], 0
    ds_read_b64_tr_b16 v[82:83], v4 offset:2048
    ds_read_b64_tr_b16 v[84:85], v4 offset:2304
    v_mfma_f32_32x32x16_bf16 v[122:137], v[86:89], v[30:33], v[122:137]
    ds_read_b64_tr_b16 v[86:87], v4 offset:3072
    ds_read_b64_tr_b16 v[88:89], v4 offset:3328
    v_mfma_f32_32x32x16_bf16 v[122:137], v[90:93], v[34:37], v[122:137]
    ds_read_b64_tr_b16 v[90:91], v4 offset:4096
    ds_read_b64_tr_b16 v[92:93], v4 offset:4352
    v_mfma_f32_32x32x16_bf16 v[122:137], v[94:97], v[38:41], v[122:137]
    ds_read_b64_tr_b16 v[94:95], v4 offset:5120
    ds_read_b64_tr_b16 v[96:97], v4 offset:5376
    v_cvt_pk_bf16_f32 v150, v106, v107
    v_cvt_pk_bf16_f32 v151, v108, v109
    v_cvt_pk_bf16_f32 v170, v110, v111
    v_mfma_f32_32x32x16_bf16 v[122:137], v[98:101], v[42:45], v[122:137]
    v_cvt_pk_bf16_f32 v171, v112, v113
    v_cvt_pk_bf16_f32 v172, v114, v115
    v_cvt_pk_bf16_f32 v173, v116, v117
    v_cvt_pk_bf16_f32 v174, v118, v119
    v_cvt_pk_bf16_f32 v175, v120, v121
    v_mfma_f32_32x32x16_bf16 v[122:137], v[102:105], v[46:49], v[122:137]
    v_mfma_f32_32x32x16_bf16 v[240:255], v[178:181], v[224:227], 0
    s_setprio 3
    ds_read_b128 v[224:227], v6 offset:8320
    v_mfma_f32_32x32x8_bf16 v[240:255], v[190:191], v[22:23], v[240:255]
    v_mfma_f32_32x32x16_bf16 v[240:255], v[182:185], v[232:235], v[240:255]
    ds_read_b128 v[232:235], v6 offset:8640
    v_mfma_f32_32x32x16_bf16 v[240:255], v[186:189], v[228:231], v[240:255]
    ds_read_b128 v[228:231], v6 offset:8480
    s_nop 3
    v_cvt_pk_bf16_f32 v162, v126, v127
    v_cvt_pk_bf16_f32 v163, v128, v129
    v_cvt_pk_bf16_f32 v164, v130, v131
    v_cvt_pk_bf16_f32 v165, v132, v133
    v_cvt_pk_bf16_f32 v166, v134, v135
    v_cvt_pk_bf16_f32 v167, v136, v137
    v_mfma_f32_32x32x16_bf16 v[192:207], v[162:165], v[146:149], v[192:207]
    v_cvt_pk_bf16_f32 v158, v122, v123
    v_cvt_pk_bf16_f32 v159, v124, v125
    v_mfma_f32_32x32x16_bf16 v[192:207], v[166:169], v[150:153], v[192:207]
    s_waitcnt lgkmcnt(2)
    v_mfma_f32_32x32x16_bf16 v[208:223], v[170:173], v[146:149], v[208:223]
    v_mfma_f32_32x32x16_bf16 v[208:223], v[174:177], v[150:153], v[208:223]
    v_rcp_f32 v253, v252
    v_mfma_f32_32x32x16_bf16 v[106:121], v[26:29], v[74:77], 0
    v_mul_f32 v240, v240, v253
    v_mfma_f32_32x32x16_bf16 v[106:121], v[30:33], v[78:81], v[106:121]
    ds_read_b32 v25, v14 offset:48
    ds_read_b64_tr_b16 v[98:99], v5 offset:1536
    ds_read_b64_tr_b16 v[100:101], v5 offset:3072
    ds_read_b64_tr_b16 v[102:103], v5 offset:1600
    ds_read_b64_tr_b16 v[104:105], v5 offset:3136
    ds_read_b64_tr_b16 v[138:139], v5 offset:1664
    ds_read_b64_tr_b16 v[140:141], v5 offset:3200
    ds_read_b64_tr_b16 v[142:143], v0 offset:0
    ds_read_b64_tr_b16 v[144:145], v0 offset:1536
    ds_read_b64_tr_b16 v[146:147], v0 offset:64
    ds_read_b64_tr_b16 v[148:149], v0 offset:1600
    ds_read_b64_tr_b16 v[150:151], v0 offset:128
    ds_read_b64_tr_b16 v[152:153], v0 offset:1664
    v_mfma_f32_32x32x16_bf16 v[106:121], v[34:37], v[82:85], v[106:121]
    v_max3_f32 v220, v192, v193, v194
    v_max3_f32 v220, v220, v195, v196
    v_max3_f32 v220, v220, v197, v198
    v_max3_f32 v220, v220, v199, v200
    v_mfma_f32_32x32x16_bf16 v[106:121], v[38:41], v[86:89], v[106:121]
    v_max3_f32 v220, v220, v201, v202
    s_waitcnt lgkmcnt(12)
    v_cmp_eq_u32 vcc, 0, v25
    v_mfma_f32_32x32x16_bf16 v[106:121], v[42:45], v[90:93], v[106:121]
    s_cbranch_vccnz L_zeo
L_keo:
    v_mfma_f32_32x32x16_bf16 v[106:121], v[46:49], v[94:97], v[106:121]
    v_max3_f32 v220, v220, v203, v204
    v_max3_f32 v220, v220, v208, v209
    v_max3_f32 v220, v220, v210, v211
    v_max3_f32 v220, v220, v212, v213
    v_max3_f32 v220, v220, v214, v215
    v_max3_f32 v220, v220, v216, v217
    v_max3_f32 v220, v220, v218, v219
    v_mov_b32 v221, v220
    s_mov_b64 exec, s[56:57]
    s_nop 2
    v_cvt_pk_bf16_f32 v178, v106, v107
    v_cvt_pk_bf16_f32 v179, v108, v109
    v_cvt_pk_bf16_f32 v180, v110, v111
    v_cvt_pk_bf16_f32 v181, v112, v113
    s_mov_b64 exec, -1
    s_mov_b64 exec, s[56:57]
    v_cvt_pk_bf16_f32 v186, v114, v115
    v_cvt_pk_bf16_f32 v187, v116, v117
    v_cvt_pk_bf16_f32 v190, v118, v119
    s_mov_b64 exec, -1
    s_setprio 0
    v_permlane32_swap_b32 v221, v220
    v_max_f32 v220, v220, v221
    v_mul_f32 v220, 0xbe96c740, v220
    v_fmamk_f32 v192, v192, 0x3e96c740, v220
    v_exp_f32 v192, v192
    v_fmamk_f32 v193, v193, 0x3e96c740, v220
    v_exp_f32 v193, v193
    v_fmamk_f32 v194, v194, 0x3e96c740, v220
    v_exp_f32 v194, v194
    v_fmamk_f32 v195, v195, 0x3e96c740, v220
    v_exp_f32 v195, v195
    v_fmamk_f32 v196, v196, 0x3e96c740, v220
    v_exp_f32 v196, v196
    v_fmamk_f32 v197, v197, 0x3e96c740, v220
    v_exp_f32 v197, v197
    v_fmamk_f32 v198, v198, 0x3e96c740, v220
    v_exp_f32 v198, v198
    v_fmamk_f32 v199, v199, 0x3e96c740, v220
    v_exp_f32 v199, v199
    v_fmamk_f32 v200, v200, 0x3e96c740, v220
    v_exp_f32 v200, v200
    v_fmamk_f32 v201, v201, 0x3e96c740, v220
    v_exp_f32 v201, v201
    s_setprio 1
    v_fmamk_f32 v202, v202, 0x3e96c740, v220
    v_exp_f32 v202, v202
    v_fmamk_f32 v203, v203, 0x3e96c740, v220
    v_exp_f32 v203, v203
    v_fmamk_f32 v204, v204, 0x3e96c740, v220
    v_exp_f32 v204, v204
    v_fmamk_f32 v208, v208, 0x3e96c740, v220
    v_exp_f32 v208, v208
    v_fmamk_f32 v209, v209, 0x3e96c740, v220
    v_exp_f32 v209, v209
    v_fmamk_f32 v210, v210, 0x3e96c740, v220
    v_exp_f32 v210, v210
    v_fmamk_f32 v211, v211, 0x3e96c740, v220
    v_exp_f32 v211, v211
    v_fmamk_f32 v212, v212, 0x3e96c740, v220
    v_exp_f32 v212, v212
    v_fmamk_f32 v213, v213, 0x3e96c740, v220
    v_exp_f32 v213, v213
    v_fmamk_f32 v214, v214, 0x3e96c740, v220
    v_exp_f32 v214, v214
    v_fmamk_f32 v215, v215, 0x3e96c740, v220
    v_exp_f32 v215, v215
    v_fmamk_f32 v216, v216, 0x3e96c740, v220
    v_exp_f32 v216, v216
    v_fmamk_f32 v217, v217, 0x3e96c740, v220
    v_exp_f32 v217, v217
    v_fmamk_f32 v218, v218, 0x3e96c740, v220
    v_exp_f32 v218, v218
    v_fmamk_f32 v219, v219, 0x3e96c740, v220
    v_cvt_pk_bf16_f32 v192, v192, v193
    v_exp_f32 v219, v219
    v_cvt_pk_bf16_f32 v193, v194, v195
    v_cvt_pk_bf16_f32 v194, v196, v197
    v_cvt_pk_bf16_f32 v195, v198, v199
    v_cvt_pk_bf16_f32 v196, v200, v201
    v_cvt_pk_bf16_f32 v197, v202, v203
    v_mul_f32 v241, v241, v253
    v_mul_f32 v242, v242, v253
    v_mul_f32 v243, v243, v253
    v_mul_f32 v244, v244, v253
    v_mul_f32 v245, v245, v253
    v_mul_f32 v246, v246, v253
    v_mul_f32 v247, v247, v253
    v_mul_f32 v248, v248, v253
    v_mul_f32 v249, v249, v253
    v_mul_f32 v250, v250, v253
    v_mul_f32 v251, v251, v253
    v_cvt_pk_bf16_f32 v22, v204, 0
    v_cvt_pk_bf16_f32 v200, v208, v209
    v_cvt_pk_bf16_f32 v201, v210, v211
    v_cvt_pk_bf16_f32 v202, v212, v213
    v_cvt_pk_bf16_f32 v203, v214, v215
    v_cvt_pk_bf16_f32 v198, v216, v217
    v_cvt_pk_bf16_f32 v199, v218, v219
    v_cvt_pk_bf16_f32 v32, v240, v241
    v_cvt_pk_bf16_f32 v33, v242, v243
    v_cvt_pk_bf16_f32 v34, v244, v245
    v_cvt_pk_bf16_f32 v35, v246, v247
    v_cvt_pk_bf16_f32 v36, v248, v249
    v_cvt_pk_bf16_f32 v37, v250, v251
    s_setprio 2
    v_mfma_f32_32x32x16_bf16 v[122:137], v[50:53], v[74:77], 0
    ds_read_b128 v[240:243], v7 offset:8320
    ds_read_b128 v[244:247], v7 offset:8480
    ds_read_b128 v[248:251], v7 offset:8640
    ds_read_b64_tr_b16 v[74:75], v0 offset:3072
    ds_read_b64_tr_b16 v[76:77], v5 offset:0
    v_mfma_f32_32x32x16_bf16 v[122:137], v[54:57], v[78:81], v[122:137]
    ds_read_b64_tr_b16 v[78:79], v0 offset:3136
    ds_read_b64_tr_b16 v[80:81], v5 offset:64
    v_mfma_f32_32x32x16_bf16 v[122:137], v[58:61], v[82:85], v[122:137]
    ds_read_b64_tr_b16 v[82:83], v0 offset:3200
    ds_read_b64_tr_b16 v[84:85], v5 offset:128
    v_mfma_f32_32x32x16_bf16 v[122:137], v[62:65], v[86:89], v[122:137]
    ds_read_b64_tr_b16 v[86:87], v0 offset:9216
    ds_read_b64_tr_b16 v[88:89], v0 offset:10752
    v_mfma_f32_32x32x16_bf16 v[122:137], v[66:69], v[90:93], v[122:137]
    ds_read_b64_tr_b16 v[90:91], v0 offset:9280
    ds_read_b64_tr_b16 v[92:93], v0 offset:10816
    ds_read_b64_tr_b16 v[66:67], v0 offset:12288
    ds_read_b64_tr_b16 v[68:69], v5 offset:9216
    v_mfma_f32_32x32x16_bf16 v[122:137], v[70:73], v[94:97], v[122:137]
    ds_read_b64_tr_b16 v[94:95], v0 offset:9344
    ds_read_b64_tr_b16 v[96:97], v0 offset:10880
    ds_read_b64_tr_b16 v[70:71], v0 offset:12352
    ds_read_b64_tr_b16 v[72:73], v5 offset:9280
    v_mfma_f32_32x32x16_bf16 v[224:239], v[162:165], v[154:157], v[224:239]
    v_mfma_f32_32x32x16_bf16 v[224:239], v[166:169], v[158:161], v[224:239]
    s_waitcnt lgkmcnt(9)
    v_mfma_f32_32x32x16_bf16 v[240:255], v[170:173], v[154:157], v[240:255]
    s_mov_b64 exec, s[56:57]
    s_nop 2
    v_cvt_pk_bf16_f32 v182, v122, v123
    v_cvt_pk_bf16_f32 v183, v124, v125
    v_cvt_pk_bf16_f32 v184, v126, v127
    v_cvt_pk_bf16_f32 v185, v128, v129
    s_mov_b64 exec, -1
    v_mfma_f32_32x32x16_bf16 v[240:255], v[174:177], v[158:161], v[240:255]
    ds_read_b32 v24, v12 offset:128
    ds_read_b64 v[26:27], v18 offset:4848
    ds_read_b64 v[28:29], v18 offset:5360
    ds_read_b64 v[30:31], v18 offset:5872
    s_mov_b64 exec, s[56:57]
    v_cvt_pk_bf16_f32 v188, v130, v131
    v_cvt_pk_bf16_f32 v189, v132, v133
    s_mov_b64 exec, -1
    v_mfma_f32_32x32x16_bf16 v[208:223], v[178:181], v[192:195], 0
    v_mfma_f32_32x32x8_bf16 v[208:223], v[190:191], v[22:23], v[208:223]
    s_setprio 3
    v_mfma_f32_32x32x16_bf16 v[208:223], v[182:185], v[200:203], v[208:223]
    s_waitcnt lgkmcnt(3)
    v_cmp_gt_u32 vcc, 1, v24
    v_mfma_f32_32x32x16_bf16 v[208:223], v[186:189], v[196:199], v[208:223]
    s_cbranch_vccnz L_zc2
L_kc2:
    v_mfma_f32_32x32x16_bf16 v[106:121], v[98:101], v[34:37], 0
    ds_read_b64_tr_b16 v[98:99], v0 offset:12416
    ds_read_b64_tr_b16 v[100:101], v5 offset:9344
    s_nop 7
    v_rcp_f32 v221, v220
    s_nop 0
    v_mul_f32 v208, v208, v221
    v_mul_f32 v209, v209, v221
    v_mul_f32 v210, v210, v221
    v_mul_f32 v211, v211, v221
    v_cvt_pk_bf16_f32 v208, v208, v209
    v_mul_f32 v212, v212, v221
    v_mul_f32 v213, v213, v221
    v_cvt_pk_bf16_f32 v209, v210, v211
    v_mul_f32 v214, v214, v221
    v_mul_f32 v215, v215, v221
    v_mul_f32 v216, v216, v221
    v_mul_f32 v217, v217, v221
    v_mul_f32 v218, v218, v221
    v_mul_f32 v219, v219, v221
    v_cvt_pk_bf16_f32 v210, v212, v213
    v_mfma_f32_32x32x16_bf16 v[50:65], v[102:105], v[34:37], 0
    ds_read_b64_tr_b16 v[102:103], v5 offset:10752
    ds_read_b64_tr_b16 v[104:105], v5 offset:12288
    v_cvt_pk_bf16_f32 v211, v214, v215
    v_cvt_pk_bf16_f32 v212, v216, v217
    v_cvt_pk_bf16_f32 v213, v218, v219
    v_mfma_f32_32x32x16_bf16 v[122:137], v[138:141], v[34:37], 0
    ds_read_b64_tr_b16 v[138:139], v5 offset:10816
    ds_read_b64_tr_b16 v[140:141], v5 offset:12352
    ds_write_b64 v17, v[208:209] offset:0
    s_waitcnt lgkmcnt(5)
    v_mfma_f32_32x32x16_bf16 v[106:121], v[142:145], v[26:29], v[106:121]
    ds_read_b64_tr_b16 v[142:143], v5 offset:10880
    ds_read_b64_tr_b16 v[144:145], v5 offset:12416
    ds_write_b64 v17, v[210:211] offset:512
    v_mfma_f32_32x32x16_bf16 v[50:65], v[146:149], v[26:29], v[50:65]
    ds_write_b64 v17, v[212:213] offset:1024
    v_max3_f32 v252, v224, v225, v226
    v_mfma_f32_32x32x16_bf16 v[122:137], v[150:153], v[26:29], v[122:137]
    v_max3_f32 v252, v252, v227, v228
    v_max3_f32 v252, v252, v229, v230
    v_max3_f32 v252, v252, v231, v232
    v_max3_f32 v252, v252, v233, v234
    v_mfma_f32_32x32x16_bf16 v[106:121], v[74:77], v[30:33], v[106:121]
    v_max3_f32 v252, v252, v235, v236
    v_max3_f32 v252, v252, v240, v241
    v_max3_f32 v252, v252, v242, v243
    v_max3_f32 v252, v252, v244, v245
    v_mfma_f32_32x32x16_bf16 v[50:65], v[78:81], v[30:33], v[50:65]
    v_max3_f32 v252, v252, v246, v247
    v_max3_f32 v252, v252, v248, v249
    v_max3_f32 v252, v252, v250, v251
    v_mov_b32 v253, v252
    v_mfma_f32_32x32x16_bf16 v[122:137], v[82:85], v[30:33], v[122:137]
    ds_add_u32 v13, v15 offset:128
    s_setprio 0
    v_permlane32_swap_b32 v253, v252
    v_max_f32 v252, v252, v253
    v_mul_f32 v252, 0xbe96c740, v252
    v_fmamk_f32 v224, v224, 0x3e96c740, v252
    v_exp_f32 v224, v224
    v_fmamk_f32 v225, v225, 0x3e96c740, v252
    v_exp_f32 v225, v225
    v_fmamk_f32 v226, v226, 0x3e96c740, v252
    v_exp_f32 v226, v226
    v_fmamk_f32 v227, v227, 0x3e96c740, v252
    v_exp_f32 v227, v227
    v_fmamk_f32 v228, v228, 0x3e96c740, v252
    v_exp_f32 v228, v228
    v_fmamk_f32 v229, v229, 0x3e96c740, v252
    v_exp_f32 v229, v229
    v_fmamk_f32 v230, v230, 0x3e96c740, v252
    v_exp_f32 v230, v230
    v_fmamk_f32 v231, v231, 0x3e96c740, v252
    s_setprio 1
    v_exp_f32 v231, v231
    v_fmamk_f32 v232, v232, 0x3e96c740, v252
    v_exp_f32 v232, v232
    v_fmamk_f32 v233, v233, 0x3e96c740, v252
    v_exp_f32 v233, v233
    v_fmamk_f32 v234, v234, 0x3e96c740, v252
    v_exp_f32 v234, v234
    v_fmamk_f32 v235, v235, 0x3e96c740, v252
    v_exp_f32 v235, v235
    v_fmamk_f32 v236, v236, 0x3e96c740, v252
    v_exp_f32 v236, v236
    v_fmamk_f32 v240, v240, 0x3e96c740, v252
    v_exp_f32 v240, v240
    v_fmamk_f32 v241, v241, 0x3e96c740, v252
    v_exp_f32 v241, v241
    v_fmamk_f32 v242, v242, 0x3e96c740, v252
    v_exp_f32 v242, v242
    v_fmamk_f32 v243, v243, 0x3e96c740, v252
    v_exp_f32 v243, v243
    v_fmamk_f32 v244, v244, 0x3e96c740, v252
    v_exp_f32 v244, v244
    v_fmamk_f32 v245, v245, 0x3e96c740, v252
    v_exp_f32 v245, v245
    v_fmamk_f32 v246, v246, 0x3e96c740, v252
    v_exp_f32 v246, v246
    v_fmamk_f32 v247, v247, 0x3e96c740, v252
    v_exp_f32 v247, v247
    v_fmamk_f32 v248, v248, 0x3e96c740, v252
    v_exp_f32 v248, v248
    v_fmamk_f32 v249, v249, 0x3e96c740, v252
    v_exp_f32 v249, v249
    v_fmamk_f32 v250, v250, 0x3e96c740, v252
    v_exp_f32 v250, v250
    v_fmamk_f32 v251, v251, 0x3e96c740, v252
    v_cvt_pk_bf16_f32 v224, v224, v225
    v_exp_f32 v251, v251
    v_cvt_pk_bf16_f32 v225, v226, v227
    v_cvt_pk_bf16_f32 v226, v228, v229
    v_cvt_pk_bf16_f32 v227, v230, v231
    v_cvt_pk_bf16_f32 v228, v232, v233
    v_cvt_pk_bf16_f32 v229, v234, v235
    v_cvt_pk_bf16_f32 v22, v236, 0
    v_cvt_pk_bf16_f32 v232, v240, v241
    v_cvt_pk_bf16_f32 v233, v242, v243
    v_cvt_pk_bf16_f32 v234, v244, v245
    v_cvt_pk_bf16_f32 v235, v246, v247
    v_cvt_pk_bf16_f32 v230, v248, v249
    v_cvt_pk_bf16_f32 v231, v250, v251
    s_setprio 2
    v_mfma_f32_32x32x16_bf16 v[240:255], v[178:181], v[224:227], 0
    ds_read_b32 v25, v12 offset:128
    ds_read_b64 v[38:39], v18 offset:0
    ds_read_b64 v[40:41], v18 offset:512
    ds_read_b64 v[42:43], v18 offset:1024
    v_mfma_f32_32x32x8_bf16 v[240:255], v[190:191], v[22:23], v[240:255]
    v_mfma_f32_32x32x16_bf16 v[240:255], v[182:185], v[232:235], v[240:255]
    v_mfma_f32_32x32x16_bf16 v[240:255], v[186:189], v[228:231], v[240:255]
    s_waitcnt lgkmcnt(3)
    v_cmp_gt_u32 vcc, 2, v25
    s_cbranch_vccnz L_zc3
L_kc3:
    s_waitcnt lgkmcnt(1)
    v_mfma_f32_32x32x16_bf16 v[106:121], v[86:89], v[38:41], v[106:121]
    v_mfma_f32_32x32x16_bf16 v[50:65], v[90:93], v[38:41], v[50:65]
    v_mfma_f32_32x32x16_bf16 v[122:137], v[94:97], v[38:41], v[122:137]
    s_setprio 3
    s_nop 3
    v_rcp_f32 v253, v252
    s_nop 0
    v_mul_f32 v240, v240, v253
    v_mul_f32 v241, v241, v253
    v_mul_f32 v242, v242, v253
    v_mul_f32 v243, v243, v253
    v_cvt_pk_bf16_f32 v44, v240, v241
    v_cvt_pk_bf16_f32 v45, v242, v243
    v_mul_f32 v244, v244, v253
    s_waitcnt lgkmcnt(0)
    v_mfma_f32_32x32x16_bf16 v[106:121], v[66:69], v[42:45], v[106:121]
    v_mul_f32 v245, v245, v253
    v_mul_f32 v246, v246, v253
    v_mul_f32 v247, v247, v253
    v_mul_f32 v248, v248, v253
    v_mul_f32 v249, v249, v253
    v_mul_f32 v250, v250, v253
    v_mul_f32 v251, v251, v253
    v_cvt_pk_bf16_f32 v46, v244, v245
    v_cvt_pk_bf16_f32 v47, v246, v247
    v_cvt_pk_bf16_f32 v48, v248, v249
    v_cvt_pk_bf16_f32 v49, v250, v251
    s_nop 1
    v_mfma_f32_32x32x16_bf16 v[106:121], v[102:105], v[46:49], v[106:121]
    v_mfma_f32_32x32x16_bf16 v[50:65], v[70:73], v[42:45], v[50:65]
    v_mfma_f32_32x32x16_bf16 v[50:65], v[138:141], v[46:49], v[50:65]
    s_nop 5
    v_mfma_f32_32x32x16_bf16 v[122:137], v[98:101], v[42:45], v[122:137]
    s_nop 2
    v_cvt_pk_bf16_f32 v106, v106, v107
    v_cvt_pk_bf16_f32 v107, v108, v109
    v_cvt_pk_bf16_f32 v108, v110, v111
    v_mfma_f32_32x32x16_bf16 v[122:137], v[142:145], v[46:49], v[122:137]
    v_cvt_pk_bf16_f32 v109, v112, v113
    v_cvt_pk_bf16_f32 v110, v114, v115
    v_cvt_pk_bf16_f32 v111, v116, v117
    v_cvt_pk_bf16_f32 v112, v118, v119
    v_cvt_pk_bf16_f32 v113, v120, v121
    v_permlane16_swap_b32 v106, v110
    v_permlane16_swap_b32 v107, v111
    v_permlane16_swap_b32 v108, v112
    v_permlane16_swap_b32 v109, v113
    buffer_store_dwordx4 v[106:109], v10, s[32:35], 0 offen offset:0 sc0 sc1 nt
    buffer_store_dwordx4 v[110:113], v11, s[32:35], 0 offen offset:0 sc0 sc1 nt
    v_cvt_pk_bf16_f32 v50, v50, v51
    v_cvt_pk_bf16_f32 v51, v52, v53
    v_cvt_pk_bf16_f32 v52, v54, v55
    v_cvt_pk_bf16_f32 v53, v56, v57
    v_cvt_pk_bf16_f32 v54, v58, v59
    v_cvt_pk_bf16_f32 v55, v60, v61
    v_cvt_pk_bf16_f32 v56, v62, v63
    v_cvt_pk_bf16_f32 v57, v64, v65
    v_permlane16_swap_b32 v50, v54
    v_permlane16_swap_b32 v51, v55
    v_permlane16_swap_b32 v52, v56
    v_permlane16_swap_b32 v53, v57
    buffer_store_dwordx4 v[50:53], v10, s[32:35], 0 offen offset:64 sc0 sc1 nt
    buffer_store_dwordx4 v[54:57], v11, s[32:35], 0 offen offset:64 sc0 sc1 nt
    v_cvt_pk_bf16_f32 v122, v122, v123
    v_cvt_pk_bf16_f32 v123, v124, v125
    v_cvt_pk_bf16_f32 v124, v126, v127
    v_cvt_pk_bf16_f32 v125, v128, v129
    v_cvt_pk_bf16_f32 v126, v130, v131
    v_cvt_pk_bf16_f32 v127, v132, v133
    v_cvt_pk_bf16_f32 v128, v134, v135
    v_cvt_pk_bf16_f32 v129, v136, v137
    v_permlane16_swap_b32 v122, v126
    v_permlane16_swap_b32 v123, v127
    v_permlane16_swap_b32 v124, v128
    v_permlane16_swap_b32 v125, v129
    buffer_store_dwordx4 v[122:125], v10, s[32:35], 0 offen offset:128 sc0 sc1 nt
    buffer_store_dwordx4 v[126:129], v11, s[32:35], 0 offen offset:128 sc0 sc1 nt
    s_endpgm
L_zea:
    ds_read_b32 v24, v14 offset:0
    s_waitcnt lgkmcnt(0)
    v_cmp_eq_u32 vcc, 0, v24
    s_cbranch_vccnz L_zea
L_yea:
    ds_read_b64_tr_b16 v[74:75], v0 offset:0
    ds_read_b64_tr_b16 v[76:77], v0 offset:256
    ds_read_b64_tr_b16 v[78:79], v0 offset:1024
    ds_read_b64_tr_b16 v[80:81], v0 offset:1280
    ds_read_b64_tr_b16 v[82:83], v0 offset:2048
    ds_read_b64_tr_b16 v[84:85], v0 offset:2304
    ds_read_b64_tr_b16 v[86:87], v0 offset:3072
    ds_read_b64_tr_b16 v[88:89], v0 offset:3328
    ds_read_b64_tr_b16 v[90:91], v0 offset:4096
    ds_read_b64_tr_b16 v[92:93], v0 offset:4352
    ds_read_b64_tr_b16 v[94:95], v0 offset:5120
    ds_read_b64_tr_b16 v[96:97], v0 offset:5376
    ds_read_b64_tr_b16 v[98:99], v1 offset:0
    ds_read_b64_tr_b16 v[100:101], v1 offset:256
    ds_read_b64_tr_b16 v[102:103], v1 offset:1024
    ds_read_b64_tr_b16 v[104:105], v1 offset:1280
    s_waitcnt lgkmcnt(0)
    s_branch L_kea
L_zc1:
    ds_read_b32 v25, v12 offset:96
    s_waitcnt lgkmcnt(0)
    v_cmp_eq_u32 vcc, 0, v25
    s_cbranch_vccnz L_zc1
L_yc1:
    ds_read_b128 v[50:53], v21 offset:0
    ds_read_b128 v[54:57], v21 offset:32
    ds_read_b128 v[58:61], v21 offset:64
    ds_read_b128 v[62:65], v21 offset:96
    s_waitcnt lgkmcnt(0)
    s_branch L_kc1
L_zed:
    ds_read_b32 v24, v14 offset:16
    s_waitcnt lgkmcnt(0)
    v_cmp_eq_u32 vcc, 0, v24
    s_cbranch_vccnz L_zed
L_yed:
    ds_read_b64_tr_b16 v[90:91], v3 offset:0
    ds_read_b64_tr_b16 v[92:93], v3 offset:256
    ds_read_b64_tr_b16 v[94:95], v3 offset:1024
    ds_read_b64_tr_b16 v[96:97], v3 offset:1280
    ds_read_b64_tr_b16 v[98:99], v3 offset:2048
    ds_read_b64_tr_b16 v[100:101], v3 offset:2304
    ds_read_b64_tr_b16 v[102:103], v3 offset:3072
    ds_read_b64_tr_b16 v[104:105], v3 offset:3328
    ds_read_b64_tr_b16 v[74:75], v3 offset:4096
    ds_read_b64_tr_b16 v[76:77], v3 offset:4352
    ds_read_b64_tr_b16 v[78:79], v3 offset:5120
    ds_read_b64_tr_b16 v[80:81], v3 offset:5376
    ds_read_b64_tr_b16 v[82:83], v2 offset:0
    ds_read_b64_tr_b16 v[84:85], v2 offset:256
    s_waitcnt lgkmcnt(0)
    s_branch L_ked
L_zeo:
    ds_read_b32 v25, v14 offset:48
    s_waitcnt lgkmcnt(0)
    v_cmp_eq_u32 vcc, 0, v25
    s_cbranch_vccnz L_zeo
L_yeo:
    ds_read_b64_tr_b16 v[98:99], v5 offset:1536
    ds_read_b64_tr_b16 v[100:101], v5 offset:3072
    ds_read_b64_tr_b16 v[102:103], v5 offset:1600
    ds_read_b64_tr_b16 v[104:105], v5 offset:3136
    ds_read_b64_tr_b16 v[138:139], v5 offset:1664
    ds_read_b64_tr_b16 v[140:141], v5 offset:3200
    ds_read_b64_tr_b16 v[142:143], v0 offset:0
    ds_read_b64_tr_b16 v[144:145], v0 offset:1536
    ds_read_b64_tr_b16 v[146:147], v0 offset:64
    ds_read_b64_tr_b16 v[148:149], v0 offset:1600
    ds_read_b64_tr_b16 v[150:151], v0 offset:128
    ds_read_b64_tr_b16 v[152:153], v0 offset:1664
    s_waitcnt lgkmcnt(0)
    s_branch L_keo
L_zc2:
    ds_read_b32 v24, v12 offset:128
    s_waitcnt lgkmcnt(0)
    v_cmp_gt_u32 vcc, 1, v24
    s_cbranch_vccnz L_zc2
L_yc2:
    ds_read_b64 v[26:27], v18 offset:4848
    ds_read_b64 v[28:29], v18 offset:5360
    ds_read_b64 v[30:31], v18 offset:5872
    s_waitcnt lgkmcnt(0)
    s_branch L_kc2
L_zc3:
    ds_read_b32 v25, v12 offset:128
    s_waitcnt lgkmcnt(0)
    v_cmp_gt_u32 vcc, 2, v25
    s_cbranch_vccnz L_zc3
L_yc3:
    ds_read_b64 v[38:39], v18 offset:0
    ds_read_b64 v[40:41], v18 offset:512
    ds_read_b64 v[42:43], v18 offset:1024
    s_waitcnt lgkmcnt(0)
    s_branch L_kc3
L_end:
    s_endpgm
.section .rodata,"a"
.p2align 6
.amdhsa_kernel standalone__window_attn_swin__vision_kernel
  .amdhsa_next_free_vgpr 256
  .amdhsa_next_free_sgpr 102
  .amdhsa_accum_offset 256
  .amdhsa_group_segment_fixed_size 0
  .amdhsa_kernarg_size 72
  .amdhsa_user_sgpr_count 2
  .amdhsa_user_sgpr_kernarg_segment_ptr 1
  .amdhsa_system_sgpr_workgroup_id_x 1
.end_amdhsa_kernel
```
